```python
import torch

def _softmax(x, axis=-1):
    return torch.softmax(x, dim=axis)
def _gelu(x):
    return torch.nn.functional.gelu(x, approximate="tanh")
def _silu(x):
    return torch.nn.functional.silu(x)
def _sigmoid(x):
    return torch.sigmoid(x)
def _layernorm(x, axis=-1, eps=1e-5):
    m = x.mean(dim=axis, keepdim=True)
    v = x.var(dim=axis, keepdim=True, unbiased=False)
    return (x - m) / torch.sqrt(v + eps)
def _scatter_add(tgt, idx, src, axis=0):
    return tgt.clone().index_add_(axis, idx, src)
def _segment_sum(src, seg, n):
    out = torch.zeros((n,) + src.shape[1:], dtype=src.dtype)
    return out.index_add_(0, seg, src)
def _pad(x, pw):
    flat = tuple(v for pair in reversed(pw) for v in pair)
    return torch.nn.functional.pad(x, flat)

kernel_name = 'sequential_preLN__sliding_block_cached__glu_gated_swiglu__decode'

def setup_inputs():

    _w = (lambda a: (lambda t: t.to(torch.bfloat16) if t.is_floating_point() else t)(torch.as_tensor(a)))
    def _A_setup():
        B, Sq, D = 1, 1, 512
        Hq, Hkv, Sk, Dh = 32, 8, 65536, 128
        assert Hq % Hkv == 0, (Hq, Hkv)
        return {
            "x": _w((lambda *s: torch.randn(*s, dtype=torch.bfloat16) * 0.05)(B, Sq, D)),
            "k_cache": _w((lambda *s: torch.randn(*s, dtype=torch.bfloat16) * 1.6)(B, Hkv, Sk, Dh)),
            "v_cache": _w((lambda *s: torch.randn(*s, dtype=torch.bfloat16) * 0.8)(B, Hkv, Sk, Dh)),
            "wq": _w((lambda *s: torch.randn(*s, dtype=torch.bfloat16) * 1.6)(D, Hq * Dh) * (D ** -0.5)),
            "wo": _w((lambda *s: torch.randn(*s, dtype=torch.bfloat16) * 0.8)(Hq * Dh, D) * ((Hq * Dh) ** -0.5)),
        }
    _A_in = _A_setup()

    def _B_setup():
        B, S, D, F = 1, 1, 512, 1792
        return {
            "x": _w((lambda *s: torch.randn(*s, dtype=torch.bfloat16) * 0.05)(B, S, D)),
            "w1": _w((lambda *s: torch.randn(*s, dtype=torch.bfloat16) * 0.4)(D, F) * (2.0 / D) ** 0.5),
            "w3": _w((lambda *s: torch.randn(*s, dtype=torch.bfloat16) * 0.4)(D, F) * (2.0 / D) ** 0.5),
            "w2": _w((lambda *s: torch.randn(*s, dtype=torch.bfloat16) * 0.4)(F, D) * (2.0 / F) ** 0.5),
        }
    _B_in = _B_setup()

    return {
        "A_x": _A_in["x"],
        "A_k_cache": _A_in["k_cache"],
        "A_v_cache": _A_in["v_cache"],
        "A_wq": _A_in["wq"],
        "A_wo": _A_in["wo"],
        "B_x": _B_in["x"],
        "B_w1": _B_in["w1"],
        "B_w3": _B_in["w3"],
        "B_w2": _B_in["w2"],
    }

def reference(A_x, A_k_cache, A_v_cache, A_wq, A_wo, B_x, B_w1, B_w3, B_w2):
    def _A_ref(x, k_cache, v_cache, wq, wo):
        B, Sq, D = x.shape
        Hq, Dh = 32, 128
        Hkv, Sk = k_cache.shape[1], k_cache.shape[2]
        W = min(4096, max(256, Sk // 4))
        rep = Hq // Hkv
        q = (lambda x, *d: x.permute(*d))((x @ wq).reshape(B, Sq, Hq, Dh), 0, 2, 1, 3)
        k = (lambda x, n, axis: torch.repeat_interleave(x, n, dim=axis))(k_cache[:, :, Sk - W:, :], rep, axis=1)
        v = (lambda x, n, axis: torch.repeat_interleave(x, n, dim=axis))(v_cache[:, :, Sk - W:, :], rep, axis=1)
        scores = torch.einsum("bhqd,bhkd->bhqk", q, k) * (Dh ** -0.5)
        p = _softmax(scores, axis=-1)
        o = torch.einsum("bhqk,bhkd->bhqd", p, v)
        return (lambda x, *d: x.permute(*d))(o, 0, 2, 1, 3).reshape(B, Sq, Hq * Dh) @ wo

    def _B_ref(x, w1, w3, w2):
        gate = torch.einsum("bsd,df->bsf", x, w1)
        up = torch.einsum("bsd,df->bsf", x, w3)
        h = _silu(gate) * up
        out = torch.einsum("bsf,fd->bsd", h, w2)
        return out

    x = A_x
    h = x + _A_ref(_layernorm(x, axis=-1), A_k_cache, A_v_cache, A_wq, A_wo)
    h2 = h + _B_ref(_layernorm(h, axis=-1), B_w1, B_w3, B_w2)
    return h2
```

```asm
; @launch grid=(256,1,1) block=(512,1,1) lds=102400
.amdgcn_target "amdgcn-amd-amdhsa--gfx950"
.text
.globl sequential_preLN__sliding_block_cached__glu_gated_swiglu__decode_kernel
.p2align 8
.type sequential_preLN__sliding_block_cached__glu_gated_swiglu__decode_kernel,@function
sequential_preLN__sliding_block_cached__glu_gated_swiglu__decode_kernel:
    s_cmp_ge_u32 s2, 256
    s_cbranch_scc1 L_end
    s_load_dwordx16 s[4:19], s[0:1], 0
    s_load_dwordx8 s[20:27], s[0:1], 64
    s_and_b32 s28, s2, 7
    s_lshr_b32 s29, s2, 3
    v_and_b32 v1, 63, v0
    v_lshrrev_b32 v20, 6, v0
    v_and_b32 v2, 7, v1
    v_readfirstlane_b32 s30, v20
    v_lshrrev_b32 v3, 3, v1
    v_lshrrev_b32 v4, 4, v1
    v_and_b32 v5, 15, v1
    s_lshr_b32 s68, s29, 3
    s_and_b32 s69, s29, 7
    s_lshl_b32 s70, s68, 20
    s_lshl_b32 s31, s28, 10
    s_add_u32 s70, s70, s31
    s_lshl_b32 s31, s69, 7
    s_add_u32 s70, s70, s31
    s_add_u32 s71, s70, 8192
    s_lshl_b32 s31, s30, 4
    v_lshl_add_u32 v20, v3, 1, s31
    v_lshlrev_b32 v21, 13, v20
    v_lshl_add_u32 v21, v2, 4, v21
    v_lshlrev_b32 v149, 4, v1
    v_mov_b32 v163, 0
    s_lshl_b32 s72, s28, 24
    s_lshl_b32 s31, s29, 15
    s_add_u32 s72, s72, s31
    s_add_u32 s72, s72, 15728640
    s_lshl_b32 s31, s30, 12
    v_xor_b32 v155, v5, v4
    v_lshlrev_b32 v155, 4, v155
    v_lshl_add_u32 v155, v4, 8, v155
    v_add_u32 v155, s31, v155
    v_xor_b32 v45, 64, v155
    v_xor_b32 v46, 128, v155
    v_xor_b32 v47, 192, v155
    v_mov_b32 v44, v155
    s_add_u32 s3, s31, 36864

    s_cmp_lg_u32 s30, 7
    s_cbranch_scc1 L_nocpf_1
    s_getpc_b64 s[84:85]
L_pcbase:
    s_lshl_b32 s31, s29, 9
    v_lshlrev_b32 v28, 7, v1
    v_add_u32 v28, s31, v28
    v_cmp_gt_u32 vcc, L_end-L_pcbase, v28
    s_and_b64 exec, vcc, 0xf
    s_cbranch_execz L_cpf_skip
    global_load_dword v88, v28, s[84:85]
L_cpf_skip:
    s_mov_b64 exec, -1
L_nocpf_1:

    s_waitcnt lgkmcnt(0)
    s_mov_b32 s40, s10
    s_mov_b32 s41, s11
    s_mov_b32 s42, 4194304
    s_mov_b32 s43, 0x20000
    s_cmp_lg_u32 s30, 0
    s_cbranch_scc1 L_nox_2
    s_mov_b32 s48, s4
    s_mov_b32 s49, s5
    s_mov_b32 s50, 1024
    s_mov_b32 s51, 0x20000
    s_mov_b32 s60, s26
    s_mov_b32 s61, s27
    s_mov_b32 s62, 536870912
    s_mov_b32 s63, 0x20000
    buffer_load_dwordx4 v[32:35], v149, s[48:51], 0 offen
    buffer_load_dword v15, v163, s[60:63], 0 offen sc1
L_nox_2:

    s_cmp_lg_u32 s30, 6
    s_cbranch_scc1 L_nopt_3
    s_mov_b32 s60, s26
    s_mov_b32 s61, s27
    s_mov_b32 s62, 536870912
    s_mov_b32 s63, 0x20000
    s_lshl_b32 s92, s28, 13
    s_lshl_b32 s31, s29, 8
    s_add_u32 s92, s92, s31
    s_add_u32 s92, s92, 4096
    v_lshl_add_u32 v28, v1, 7, s92
    s_lshl_b32 s92, s28, 8
    s_and_b32 s31, s29, 1
    s_lshl_b32 s31, s31, 7
    s_add_u32 s92, s92, s31
    s_add_u32 s92, s92, 69632
    v_writelane_b32 v28, s92, 2
    s_mov_b64 exec, 7
    buffer_load_dword v89, v28, s[60:63], 0 offen sc1
    s_mov_b64 exec, -1
L_nopt_3:

    buffer_load_dwordx4 v[36:39], v21, s[40:43], s70 offen nt
    buffer_load_dwordx4 v[40:43], v21, s[40:43], s71 offen nt
    s_mov_b32 s32, s6
    s_mov_b32 s33, s7
    s_mov_b32 s34, 134217728
    s_mov_b32 s35, 0x20000
    s_barrier
    s_mov_b32 m0, s3
    s_nop 0
    buffer_load_dwordx4 v44, s[32:35], s72 offen offset:0 nt lds
    s_mov_b32 s60, s26
    s_mov_b32 s61, s27
    s_mov_b32 s62, 536870912
    s_mov_b32 s63, 0x20000
    s_mov_b32 s36, s8
    s_mov_b32 s37, s9
    s_mov_b32 s38, 134217728
    s_mov_b32 s39, 0x20000
    s_mov_b32 s44, s12
    s_mov_b32 s45, s13
    s_mov_b32 s46, 4194304
    s_mov_b32 s47, 0x20000
    s_mov_b32 s52, s22
    s_mov_b32 s53, s23
    s_mov_b32 s54, 1024
    s_mov_b32 s55, 0x20000
    s_mov_b32 s56, s20
    s_mov_b32 s57, s21
    s_mov_b32 s58, 1835008
    s_mov_b32 s59, 0x20000
    s_mov_b32 s65, 0xff
    s_mov_b32 s66, 0xffffff00
    s_mov_b32 s97, 0x200000
    s_mov_b32 s93, 0x3db504f3
    s_mov_b32 s94, 0x3fb8aa3b
    s_mov_b32 s88, 64
    s_mov_b32 s89, 0
    s_getreg_b32 s76, hwreg(HW_REG_XCC_ID)
    s_and_b32 s76, s76, 15
    s_lshl_b32 s81, s68, 3
    s_add_u32 s81, s81, s28
    v_and_b32 v28, 1, v1
    v_cmp_eq_u32 vcc, 1, v28
    v_mov_b32 v29, 0xffff
    v_mov_b32 v30, 0xffff0000
    v_cndmask_b32 v29, v29, v30, vcc
    v_bfe_u32 v28, v1, 1, 2

    v_cmp_eq_u32 vcc, 0, v28
    s_nop 1
    v_cndmask_b32 v6, 0, v29, vcc
    v_cmp_eq_u32 vcc, 1, v28
    s_nop 1
    v_cndmask_b32 v7, 0, v29, vcc
    v_cmp_eq_u32 vcc, 2, v28
    s_nop 1
    v_cndmask_b32 v8, 0, v29, vcc
    v_cmp_eq_u32 vcc, 3, v28
    s_nop 1
    v_cndmask_b32 v9, 0, v29, vcc
    s_lshl_b32 s31, s68, 8
    v_lshl_add_u32 v22, v20, 1, s31
    s_lshr_b32 s95, s30, 2
    s_lshl_b32 s95, s95, 5
    s_and_b32 s31, s30, 3
    s_lshl_b32 s92, s31, 1
    s_add_u32 s95, s95, s92
    s_lshl_b32 s92, s69, 6
    s_add_u32 s95, s95, s92
    v_and_b32 v151, 1, v1
    v_lshlrev_b32 v151, 1, v151
    v_lshl_add_u32 v151, v4, 4, v151
    s_lshl_b32 s92, s95, 1
    v_add_u32 v24, s92, v151
    s_mul_i32 s92, s30, 528
    v_lshlrev_b32 v150, 4, v2
    v_lshl_add_u32 v17, v4, 7, v150
    v_add_u32 v17, s92, v17
    s_lshl_b32 s92, s30, 5
    s_movk_i32 s31, 528
    v_mul_lo_u32 v154, v2, s31
    v_and_b32 v153, 1, v3
    v_lshlrev_b32 v153, 4, v153
    v_add3_u32 v154, v154, v153, s92
    v_lshlrev_b32 v162, 2, v1
    s_lshl_b32 s73, s28, 13
    s_add_u32 s73, s73, 4096
    s_add_u32 s74, s73, 4096
    s_lshl_b32 s31, s68, 11
    s_add_u32 s86, s73, s31
    s_lshl_b32 s31, s69, 8
    s_add_u32 s86, s86, s31
    s_lshl_b32 s31, s30, 5
    s_add_u32 s86, s86, s31
    s_lshl_b32 s75, s28, 8
    s_add_u32 s75, s75, 69632
    s_lshl_b32 s31, s29, 3
    s_add_u32 s87, s75, s31

    s_cmp_lg_u32 s30, 0
    s_cbranch_scc1 L_lndone_5
    s_waitcnt vmcnt(4)
    v_lshlrev_b32 v96, 16, v32
    v_and_b32 v97, 0xffff0000, v32
    v_lshlrev_b32 v98, 16, v33
    v_and_b32 v99, 0xffff0000, v33
    v_lshlrev_b32 v100, 16, v34
    v_and_b32 v101, 0xffff0000, v34
    v_lshlrev_b32 v102, 16, v35
    v_and_b32 v103, 0xffff0000, v35
    v_add_f32 v28, v96, v97
    v_mul_f32 v29, v96, v96
    v_add_f32 v30, v98, v99
    v_mul_f32 v31, v97, v97
    v_add_f32 v28, v28, v100
    v_fmac_f32 v29, v98, v98
    v_add_f32 v30, v30, v101
    v_fmac_f32 v31, v99, v99
    v_add_f32 v28, v28, v102
    v_fmac_f32 v29, v100, v100
    v_add_f32 v30, v30, v103
    v_fmac_f32 v31, v101, v101
    v_fmac_f32 v29, v102, v102
    v_fmac_f32 v31, v103, v103
    v_add_f32 v28, v28, v30
    v_add_f32 v29, v29, v31
    ds_write_b128 v149, v[32:35] offset:23808

    s_nop 0
    v_add_f32_dpp v28, v28, v28 quad_perm:[1,0,3,2] row_mask:0xf bank_mask:0xf
    v_add_f32_dpp v29, v29, v29 quad_perm:[1,0,3,2] row_mask:0xf bank_mask:0xf
    s_nop 0
    v_add_f32_dpp v28, v28, v28 quad_perm:[2,3,0,1] row_mask:0xf bank_mask:0xf
    v_add_f32_dpp v29, v29, v29 quad_perm:[2,3,0,1] row_mask:0xf bank_mask:0xf
    s_nop 0
    v_add_f32_dpp v28, v28, v28 row_half_mirror row_mask:0xf bank_mask:0xf
    v_add_f32_dpp v29, v29, v29 row_half_mirror row_mask:0xf bank_mask:0xf
    s_nop 0
    v_add_f32_dpp v28, v28, v28 row_mirror row_mask:0xf bank_mask:0xf
    v_add_f32_dpp v29, v29, v29 row_mirror row_mask:0xf bank_mask:0xf
    v_mov_b32 v30, v28
    v_mov_b32 v31, v29
    s_nop 0
    v_permlane16_swap_b32 v28, v30
    v_permlane16_swap_b32 v29, v31
    v_add_f32 v28, v28, v30
    v_add_f32 v29, v29, v31

    v_mov_b32 v30, v28
    v_mov_b32 v31, v29
    s_nop 0
    v_permlane32_swap_b32 v28, v30
    v_permlane32_swap_b32 v29, v31
    v_add_f32 v28, v28, v30
    v_add_f32 v29, v29, v31

    v_mul_f32 v28, 0x3b000000, v28
    v_mul_f32 v29, 0x3b000000, v29
    v_fma_f32 v29, -v28, v28, v29
    v_max_f32 v29, 0, v29
    v_cvt_pk_bf16_f32 v29, v29, v28
    v_and_b32 v28, 0xffff0000, v29
    v_lshlrev_b32 v29, 16, v29
    v_add_f32 v29, 0x3727c5ac, v29

    v_cvt_pk_bf16_f32 v29, v29, v29
    v_and_b32 v29, 0xffff0000, v29
    v_sqrt_f32 v29, v29
    s_nop 0
    v_cvt_pk_bf16_f32 v29, v29, v29
    v_and_b32 v29, 0xffff0000, v29
    v_rcp_f32 v29, v29
    s_waitcnt vmcnt(3)
    v_mov_b32 v30, v15
    s_nop 0
    ds_write_b96 v163, v[28:30] offset:22528
    s_waitcnt lgkmcnt(0)
L_lndone_5:
    s_barrier
    ds_read_b96 v[28:30], v163 offset:22528
    ds_read_b32 v23, v22 offset:23808
    ds_read_u16 v15, v24 offset:23808

    s_waitcnt lgkmcnt(1)
    v_lshlrev_b32 v22, 16, v23
    v_and_b32 v23, 0xffff0000, v23
    v_sub_f32 v22, v22, v28
    v_sub_f32 v23, v23, v28
    v_cvt_pk_bf16_f32 v23, v22, v23
    v_lshlrev_b32 v22, 16, v23
    v_and_b32 v23, 0xffff0000, v23
    v_mul_f32 v22, v22, v29
    v_mul_f32 v23, v23, v29
    v_cvt_pk_bf16_f32 v22, v22, v22
    v_cvt_pk_bf16_f32 v23, v23, v23

    v_and_b32 v120, v22, v6
    v_and_b32 v121, v22, v7
    v_and_b32 v122, v22, v8
    v_and_b32 v123, v22, v9
    v_and_b32 v124, v23, v6
    v_and_b32 v125, v23, v7
    v_and_b32 v126, v23, v8
    v_and_b32 v127, v23, v9
    s_waitcnt vmcnt(2)
    s_mov_b32 m0, s3
    s_nop 0
    buffer_load_dwordx4 v45, s[32:35], s72 offen offset:1024 nt lds
    s_mov_b32 m0, s3
    s_nop 0
    buffer_load_dwordx4 v46, s[32:35], s72 offen offset:2048 nt lds
    s_mov_b32 m0, s3
    s_nop 0
    buffer_load_dwordx4 v47, s[32:35], s72 offen offset:3072 nt lds
    s_waitcnt vmcnt(4)
    v_mfma_f32_16x16x32_bf16 v[112:115], v[36:39], v[120:123], 0
    v_mfma_f32_16x16x32_bf16 v[112:115], v[40:43], v[124:127], v[112:115]
    v_readfirstlane_b32 s64, v30
    s_add_u32 s64, s64, 2654435769
    v_mov_b32 v156, s64
    v_lshrrev_b32 v157, 8, v156
    v_lshrrev_b32 v158, 16, v156
    v_lshrrev_b32 v159, 24, v156

    s_mov_b32 exec_lo, 0x00ff00ff
    s_mov_b32 exec_hi, 0xff00ff00
    ds_write_b128 v17, v[112:115] offset:0
    s_mov_b64 exec, -1
    s_waitcnt lgkmcnt(0)
    s_barrier
    ds_read_b128 v[116:119], v154 offset:0
    ds_read_b128 v[96:99], v154 offset:256
    s_waitcnt lgkmcnt(0)
    v_pk_add_f32 v[116:117], v[116:117], v[96:97]
    v_pk_add_f32 v[118:119], v[118:119], v[98:99]
    s_nop 0

    v_add_f32_dpp v116, v116, v116 quad_perm:[1,0,3,2] row_mask:0xf bank_mask:0xf
    v_add_f32_dpp v117, v117, v117 quad_perm:[1,0,3,2] row_mask:0xf bank_mask:0xf
    v_add_f32_dpp v118, v118, v118 quad_perm:[1,0,3,2] row_mask:0xf bank_mask:0xf
    v_add_f32_dpp v119, v119, v119 quad_perm:[1,0,3,2] row_mask:0xf bank_mask:0xf
    v_add_f32_dpp v116, v116, v116 quad_perm:[2,3,0,1] row_mask:0xf bank_mask:0xf
    v_add_f32_dpp v117, v117, v117 quad_perm:[2,3,0,1] row_mask:0xf bank_mask:0xf
    v_add_f32_dpp v118, v118, v118 quad_perm:[2,3,0,1] row_mask:0xf bank_mask:0xf
    v_add_f32_dpp v119, v119, v119 quad_perm:[2,3,0,1] row_mask:0xf bank_mask:0xf
    v_add_f32_dpp v116, v116, v116 row_half_mirror row_mask:0xf bank_mask:0xf
    v_add_f32_dpp v117, v117, v117 row_half_mirror row_mask:0xf bank_mask:0xf
    v_add_f32_dpp v118, v118, v118 row_half_mirror row_mask:0xf bank_mask:0xf
    v_add_f32_dpp v119, v119, v119 row_half_mirror row_mask:0xf bank_mask:0xf
    v_bfi_b32 v116, s65, v156, v116
    v_bfi_b32 v117, s65, v157, v117
    v_bfi_b32 v118, s65, v158, v118
    v_bfi_b32 v119, s65, v159, v119
    s_mov_b64 exec, 0x101
    buffer_store_dwordx4 v[116:119], v153, s[60:63], s86 offen

    s_mov_b64 exec, -1
    s_cmp_lg_u32 s30, 1
    s_cbranch_scc1 L_noqx_6
    v_mov_b32 v112, s76
    v_mov_b32 v113, s64
    s_add_u32 s92, s87, 0
    s_mov_b64 exec, 1
    buffer_store_dwordx2 v[112:113], v163, s[60:63], s92 offen
    s_mov_b64 exec, -1
L_noqx_6:

    s_barrier
    v_xor_b32 v155, v5, v4
    v_lshlrev_b32 v155, 4, v155
    v_lshl_add_u32 v155, v5, 8, v155
    v_add_u32 v155, s3, v155
    v_lshlrev_b32 v19, 1, v4
    v_xor_b32 v19, v5, v19
    s_lshl_b32 s31, s30, 2
    s_and_b32 s31, s31, 8
    v_xor_b32 v19, s31, v19
    v_lshlrev_b32 v19, 4, v19
    v_lshl_add_u32 v19, v4, 8, v19
    s_lshl_b32 s31, s30, 12
    v_add_u32 v19, s31, v19
    v_lshrrev_b32 v13, 2, v1
    v_lshlrev_b32 v13, 4, v13
    v_and_b32 v28, 3, v1
    s_movk_i32 s31, 1056
    v_mul_lo_u32 v28, v28, s31
    v_add_u32 v12, v13, v28
    v_lshrrev_b32 v28, 1, v1
    v_lshlrev_b32 v18, 8, v28
    v_and_b32 v28, 1, v1
    v_lshl_add_u32 v18, v28, 4, v18
    s_lshl_b32 s31, s30, 5
    v_add_u32 v18, s31, v18
    v_lshlrev_b32 v139, 2, v0
    v_and_b32 v28, 31, v1
    v_lshlrev_b32 v140, 3, v28
    v_lshlrev_b32 v141, 4, v28
    s_lshl_b32 s31, s30, 14
    v_and_b32 v28, 1, v3
    v_lshl_add_u32 v28, v4, 2, v28
    v_lshl_add_u32 v128, v28, 10, v150
    v_add_u32 v128, s31, v128
    s_lshl_b32 s80, s28, 19
    s_lshl_b32 s31, s68, 17
    s_add_u32 s80, s80, s31
    s_lshl_b32 s31, s69, 7
    s_add_u32 s80, s80, s31
    v_and_b32 v129, 0x1e0, v0
    v_and_b32 v28, 3, v1
    v_lshl_add_u32 v129, v28, 3, v129
    v_bfe_u32 v28, v1, 2, 3
    v_add_lshl_u32 v129, v129, v28, 1
    v_and_b32 v28, 3, v1
    v_lshlrev_b32 v130, 8, v28
    v_lshl_add_u32 v130, v4, 4, v130
    v_lshlrev_b32 v152, 5, v28
    s_lshl_b32 s31, s30, 2
    v_add_u32 v131, s31, v152

    v_lshlrev_b32 v15, 16, v15
    v_and_b32 v28, 3, v1
    v_lshlrev_b32 v28, 3, v28
    v_lshrrev_b32 v11, v28, s64

    s_add_u32 m0, s3, 32768
    s_nop 0
    buffer_load_dwordx4 v19, s[36:39], s72 offen offset:0 nt lds
    s_add_u32 m0, s3, 32768
    s_nop 0
    buffer_load_dwordx4 v19, s[36:39], s72 offen offset:1024 nt lds
    v_and_b32 v28, 8, v1
    v_cmp_eq_u32 vcc, 0, v28
    v_mov_b32 v28, s18
    v_mov_b32 v29, s16
    v_cndmask_b32 v132, v28, v29, vcc
    v_mov_b32 v28, s19
    v_mov_b32 v29, s17
    v_cndmask_b32 v133, v28, v29, vcc
    v_lshl_add_u32 v28, v4, 3, s95
    s_movk_i32 s31, 3584
    v_mul_lo_u32 v28, v28, s31
    v_add_u32 v28, v28, v150
    s_min_u32 s31, s81, 27
    s_lshl_b32 s31, s31, 7
    v_add_u32 v28, s31, v28
    v_add_co_u32 v132, vcc, v132, v28
    s_nop 1
    v_addc_co_u32 v133, vcc, 0, v133, vcc
    s_lshl_b32 s31, s30, 13
    v_lshl_add_u32 v134, v3, 10, v150
    v_add_u32 v134, s31, v134
    s_lshl_b32 s82, s81, 16
    s_lshl_b32 s31, s69, 7
    s_add_u32 s82, s82, s31
    v_and_b32 v28, 3, v1
    s_movk_i32 s31, 320
    v_mul_lo_u32 v29, v28, s31
    v_lshl_add_u32 v136, v4, 4, v29
    v_lshl_add_u32 v135, v4, 6, v29
    s_lshl_b32 s31, s30, 3
    v_add_u32 v135, s31, v135
    v_lshlrev_b32 v137, 14, v28
    v_lshl_add_u32 v137, v4, 9, v137
    s_lshl_b32 s31, s30, 11
    v_add_u32 v137, s31, v137
    v_lshlrev_b32 v143, 9, v28
    v_bfe_u32 v28, v1, 2, 2
    v_bfe_u32 v29, v1, 1, 1
    s_lshl_b32 s31, s30, 1
    v_add_u32 v29, s31, v29
    v_lshlrev_b32 v138, 1, v28
    v_xor_b32 v29, v29, v138
    v_and_b32 v138, 1, v4
    v_lshlrev_b32 v138, 3, v138
    v_xor_b32 v29, v29, v138
    v_lshl_add_u32 v28, v4, 5, v28
    v_lshlrev_b32 v138, 8, v28
    v_lshl_add_u32 v138, v29, 4, v138
    v_and_b32 v28, 1, v1
    v_lshl_add_u32 v138, v28, 3, v138
    v_add_u32 v138, 69632, v138
    s_lshl_b32 s92, s28, 16
    s_add_u32 s92, s92, 131072
    s_lshl_b32 s31, s29, 4
    s_add_u32 s83, s92, s31
    s_lshl_b32 s31, s68, 14
    s_add_u32 s78, s92, s31
    s_lshl_b32 s31, s30, 11
    s_add_u32 s78, s78, s31
    s_lshl_b32 s92, s28, 11
    s_add_u32 s92, s92, 73728
    s_lshl_b32 s31, s29, 4
    s_add_u32 s84, s92, s31
    s_lshl_b32 s31, s68, 9
    s_add_u32 s77, s92, s31
    v_lshlrev_b32 v142, 4, v5
    v_lshl_add_u32 v142, v4, 9, v142
    v_lshlrev_b32 v146, 3, v2
    s_lshl_b32 s85, s69, 13
    s_add_u32 s8, s85, 1048576
    s_add_u32 s85, s85, 655360
    s_lshl_b32 s31, s28, 10
    s_add_u32 s79, s85, s31
    s_lshl_b32 s31, s68, 8
    s_add_u32 s79, s79, s31
    s_lshl_b32 s31, s81, 8
    s_add_u32 s7, s8, s31
    s_mul_i32 s31, s30, 1040
    v_add_u32 v144, s31, v149
    v_bfe_u32 v145, v0, 8, 1
    v_lshlrev_b32 v145, 6, v145
    v_lshl_add_u32 v145, v3, 2, v145
    v_bfe_u32 v28, v0, 6, 2
    v_add_lshl_u32 v145, v145, v28, 2
    s_movk_i32 s31, 1040
    v_mul_lo_u32 v28, v2, s31
    v_add_u32 v145, v145, v28
    v_lshrrev_b32 v147, 3, v0
    v_lshlrev_b32 v147, 7, v147
    s_lshl_b32 s31, s30, 3
    v_mov_b32 v148, s31
    v_mov_b32 v160, 0x3f803f80
    v_mov_b32 v161, 0x3f803f80
    s_lshl_b32 s92, s81, 13
    s_add_u32 s92, s92, 720896
    s_lshl_b32 s31, s69, 4
    s_add_u32 s96, s92, s31
    s_lshl_b32 s6, s81, 7
    s_add_u32 s6, s6, 983040
    s_add_u32 s4, s6, s31
    s_lshl_b32 s31, s30, 10
    s_add_u32 s5, s92, s31
    s_lshl_b32 s9, s95, 1

    s_add_u32 m0, s3, 32768
    s_nop 0
    buffer_load_dwordx4 v19, s[36:39], s72 offen offset:2048 nt lds
    s_add_u32 m0, s3, 32768
    s_nop 0
    buffer_load_dwordx4 v19, s[36:39], s72 offen offset:3072 nt lds
    s_waitcnt vmcnt(4)
    buffer_load_dword v92, v139, s[60:63], s73 offen sc1
    buffer_load_dword v93, v139, s[60:63], s73 offen offset:2048 sc1
    buffer_load_dword v94, v139, s[60:63], s74 offen sc1
    buffer_load_dword v95, v139, s[60:63], s74 offen offset:2048 sc1
    buffer_load_dwordx2 v[90:91], v140, s[60:63], s75 offen sc1
    s_barrier
    s_lshl_b32 s92, s28, 16
    s_lshl_b32 s31, s29, 11
    s_add_u32 s92, s92, s31
    s_lshl_b32 s31, s30, 8
    s_add_u32 s92, s92, s31
    s_add_u32 s92, s92, 131072
    v_lshl_add_u32 v28, v1, 7, s92
    s_lshl_b32 s92, s81, 13
    s_lshl_b32 s31, s69, 10
    s_add_u32 s92, s92, s31
    s_lshl_b32 s31, s30, 7
    s_add_u32 s92, s92, s31
    s_add_u32 s92, s92, 720896
    v_writelane_b32 v28, s92, 2
    s_lshl_b32 s92, s28, 11
    s_and_b32 s31, s29, 15
    s_lshl_b32 s31, s31, 7
    s_add_u32 s92, s92, s31
    s_add_u32 s92, s92, 73728
    s_lshl_b32 s31, s81, 7
    s_add_u32 s31, s31, 983040
    s_bitcmp1_b32 s30, 0
    s_cselect_b32 s92, s31, s92
    v_writelane_b32 v28, s92, 3
    s_lshl_b32 s92, s29, 11
    s_lshl_b32 s31, s30, 8
    s_add_u32 s92, s92, s31
    s_add_u32 s92, s92, 655360
    v_writelane_b32 v28, s92, 4
    s_add_u32 s92, s92, 128
    v_writelane_b32 v28, s92, 5
    s_lshl_b32 s92, s28, 13
    s_lshl_b32 s31, s29, 8
    s_add_u32 s92, s92, s31
    s_and_b32 s31, s30, 1
    s_lshl_b32 s31, s31, 7
    s_add_u32 s92, s92, s31
    s_add_u32 s92, s92, 1048576
    v_writelane_b32 v28, s92, 6
    s_cmp_lt_u32 s30, 2
    s_cselect_b32 s31, 15, 7
    s_mov_b32 exec_lo, s31
    s_mov_b32 exec_hi, 0

    buffer_load_dword v89, v28, s[60:63], 0 offen sc1
    s_mov_b64 exec, -1
    buffer_load_dwordx4 v[76:79], v128, s[44:47], s80 offen offset:0 nt
    v_xor_b32 v29, 64, v155
    v_xor_b32 v30, 128, v155
    v_xor_b32 v31, 192, v155
    ds_read_b128 v[44:47], v155
    ds_read_b128 v[48:51], v29
    ds_read_b128 v[52:55], v30
    ds_read_b128 v[56:59], v31
    buffer_load_dword v92, v139, s[60:63], s73 offen sc1
    buffer_load_dword v93, v139, s[60:63], s73 offen offset:2048 sc1
    buffer_load_dword v94, v139, s[60:63], s74 offen sc1
    buffer_load_dword v95, v139, s[60:63], s74 offen offset:2048 sc1
    buffer_load_dwordx2 v[90:91], v140, s[60:63], s75 offen sc1
    s_barrier
    buffer_load_dwordx4 v[80:83], v128, s[44:47], s80 offen offset:2048 nt
    s_waitcnt vmcnt(8)
    v_cmpx_eq_u32_sdwa vcc, v92, v11 src0_sel:BYTE_0 src1_sel:BYTE_0
    v_cmpx_eq_u32_sdwa vcc, v93, v11 src0_sel:BYTE_0 src1_sel:BYTE_0
    v_cmpx_eq_u32_sdwa vcc, v94, v11 src0_sel:BYTE_0 src1_sel:BYTE_0
    v_cmpx_eq_u32_sdwa vcc, v95, v11 src0_sel:BYTE_0 src1_sel:BYTE_0
    v_cmpx_eq_u32 vcc, s64, v91
    s_cmp_eq_u64 exec, -1
    s_mov_b64 exec, -1
    s_cbranch_scc1 L_qok_8
    s_waitcnt vmcnt(1)
L_qchk_7:
    v_cmpx_eq_u32_sdwa vcc, v92, v11 src0_sel:BYTE_0 src1_sel:BYTE_0
    v_cmpx_eq_u32_sdwa vcc, v93, v11 src0_sel:BYTE_0 src1_sel:BYTE_0
    v_cmpx_eq_u32_sdwa vcc, v94, v11 src0_sel:BYTE_0 src1_sel:BYTE_0
    v_cmpx_eq_u32_sdwa vcc, v95, v11 src0_sel:BYTE_0 src1_sel:BYTE_0
    v_cmpx_eq_u32 vcc, s64, v91
    s_cmp_eq_u64 exec, -1
    s_mov_b64 exec, -1
    s_cbranch_scc1 L_qok_8
    s_sub_u32 s97, s97, 1
    s_cbranch_scc1 L_end
    s_sub_u32 s88, s88, 1
    s_cmp_lg_u32 s88, 0
    s_cbranch_scc1 L_qre_9
    s_add_u32 s92, s86, 1572864
    s_mov_b64 exec, 0x101
    buffer_store_dwordx4 v[116:119], v153, s[60:63], s92 offen sc1

    s_mov_b64 exec, -1
    s_cmp_lg_u32 s30, 1
    s_cbranch_scc1 L_noqx_11
    v_mov_b32 v112, s76
    v_mov_b32 v113, s64
    s_add_u32 s92, s87, 1572864
    s_mov_b64 exec, 1
    buffer_store_dwordx2 v[112:113], v163, s[60:63], s92 offen sc1
    s_mov_b64 exec, -1
L_noqx_11:

    s_mov_b32 s89, 1
    s_add_u32 s73, s73, 1572864
    s_add_u32 s74, s74, 1572864
    s_add_u32 s75, s75, 1572864
L_qre_9:

    buffer_load_dword v92, v139, s[60:63], s73 offen sc1
    buffer_load_dword v93, v139, s[60:63], s73 offen offset:2048 sc1
    buffer_load_dword v94, v139, s[60:63], s74 offen sc1
    buffer_load_dword v95, v139, s[60:63], s74 offen offset:2048 sc1
    buffer_load_dwordx2 v[90:91], v140, s[60:63], s75 offen sc1
    s_waitcnt vmcnt(0)
    s_branch L_qchk_7
L_qok_8:
    v_and_b32 v20, s66, v92
    v_and_b32 v21, s66, v93
    v_and_b32 v22, s66, v94
    v_and_b32 v23, s66, v95
    v_add_f32 v20, v20, v21
    v_add_f32 v22, v22, v23
    v_add_f32 v20, v20, v22
    v_cvt_pk_bf16_f32 v20, v20, v20
    ds_write_b16 v129, v20 offset:20480
    v_cmp_ne_u32 vcc, s76, v90
    s_cmp_eq_u64 vcc, 0
    s_cselect_b32 s67, 1, 0
    s_cbranch_scc1 L_qgo_10
    s_cmp_eq_u32 s89, 1
    s_cbranch_scc1 L_qgo_10

    s_add_u32 s92, s86, 1572864
    s_mov_b64 exec, 0x101
    buffer_store_dwordx4 v[116:119], v153, s[60:63], s92 offen sc1

    s_mov_b64 exec, -1
    s_cmp_lg_u32 s30, 1
    s_cbranch_scc1 L_noqx_12
    v_mov_b32 v112, s76
    v_mov_b32 v113, s64
    s_add_u32 s92, s87, 1572864
    s_mov_b64 exec, 1
    buffer_store_dwordx2 v[112:113], v163, s[60:63], s92 offen sc1
    s_mov_b64 exec, -1
L_noqx_12:

L_qgo_10:
    s_waitcnt lgkmcnt(0)
    s_barrier
    ds_read_b128 v[96:99], v130 offset:20480
    ds_read_b128 v[100:103], v130 offset:20544
    ds_read_b128 v[104:107], v130 offset:20608
    ds_read_b128 v[108:111], v130 offset:20672
    s_waitcnt lgkmcnt(3)
    v_mfma_f32_16x16x32_bf16 v[112:115], v[44:47], v[96:99], 0
    s_waitcnt lgkmcnt(2)
    v_mfma_f32_16x16x32_bf16 v[112:115], v[48:51], v[100:103], v[112:115]
    s_waitcnt lgkmcnt(1)
    v_mfma_f32_16x16x32_bf16 v[112:115], v[52:55], v[104:107], v[112:115]
    s_waitcnt lgkmcnt(0)
    v_mfma_f32_16x16x32_bf16 v[112:115], v[56:59], v[108:111], v[112:115]
    s_cmp_ge_u32 s81, 28
    s_cbranch_scc1 L_noffnld_13
    global_load_dwordx4 v[84:87], v[132:133], off nt
    global_load_dwordx4 v[88:91], v[132:133], off offset:3584 nt
L_noffnld_13:
    s_nop 7
    v_cvt_pk_bf16_f32 v24, v112, v113
    v_cvt_pk_bf16_f32 v25, v114, v115
    v_lshlrev_b32 v20, 16, v24
    v_and_b32 v21, 0xffff0000, v24
    v_lshlrev_b32 v22, 16, v25
    v_and_b32 v23, 0xffff0000, v25
    v_mul_f32 v20, s93, v20
    v_mul_f32 v21, s93, v21
    v_mul_f32 v22, s93, v22
    v_mul_f32 v23, s93, v23
    v_cvt_pk_bf16_f32 v24, v20, v21
    v_cvt_pk_bf16_f32 v25, v22, v23
    v_lshlrev_b32 v20, 16, v24
    v_and_b32 v21, 0xffff0000, v24
    v_lshlrev_b32 v22, 16, v25
    v_and_b32 v23, 0xffff0000, v25
    v_max3_f32 v24, v20, v21, v22
    v_max_f32 v24, v24, v23
    v_mov_b32 v25, v24
    v_mul_f32 v20, s94, v20
    v_mul_f32 v21, s94, v21
    v_permlane16_swap_b32 v24, v25
    v_max_f32 v24, v24, v25
    v_mov_b32 v25, v24
    v_mul_f32 v22, s94, v22
    v_mul_f32 v23, s94, v23
    v_permlane32_swap_b32 v24, v25
    v_max_f32 v24, v24, v25
    s_mov_b64 exec, 0xf
    ds_write_b32 v131, v24 offset:21504
    s_mov_b64 exec, -1

    s_waitcnt lgkmcnt(0)
    s_barrier
    ds_read_b128 v[96:99], v152 offset:21504
    ds_read_b128 v[100:103], v152 offset:21520
    s_waitcnt lgkmcnt(0)
    v_max3_f32 v24, v96, v97, v98
    v_max3_f32 v25, v99, v100, v101
    v_max3_f32 v24, v24, v102, v103
    v_max_f32 v24, v24, v25
    v_mul_f32 v25, s94, v24
    v_sub_f32 v20, v20, v25
    v_sub_f32 v21, v21, v25
    v_sub_f32 v22, v22, v25
    v_sub_f32 v23, v23, v25
    v_exp_f32 v20, v20
    v_exp_f32 v21, v21
    v_exp_f32 v22, v22
    v_exp_f32 v23, v23
    v_cvt_pk_bf16_f32 v26, v20, v21
    v_cvt_pk_bf16_f32 v27, v22, v23
    s_mov_b32 exec_lo, 0x000f000f
    s_mov_b32 exec_hi, 0x000f000f
    ds_write_b64 v135, v[26:27] offset:30208
    s_mov_b64 exec, -1

    s_waitcnt lgkmcnt(0)
    s_barrier
    ds_read_b64_tr_b16 v[60:61], v138 offset:0
    ds_read_b64_tr_b16 v[62:63], v138 offset:4096
    ds_read_b128 v[96:99], v136 offset:30208
    ds_read_b64_tr_b16 v[64:65], v138 offset:1024
    ds_read_b64_tr_b16 v[66:67], v138 offset:5120
    ds_read_b128 v[100:103], v136 offset:30272
    ds_read_b64_tr_b16 v[68:69], v138 offset:2048
    ds_read_b64_tr_b16 v[70:71], v138 offset:6144
    ds_read_b128 v[104:107], v136 offset:30336
    ds_read_b64_tr_b16 v[72:73], v138 offset:3072
    ds_read_b64_tr_b16 v[74:75], v138 offset:7168
    ds_read_b128 v[108:111], v136 offset:30400
    s_waitcnt lgkmcnt(9)
    v_mfma_f32_16x16x32_bf16 v[112:115], v[60:63], v[96:99], 0
    s_waitcnt lgkmcnt(6)
    v_mfma_f32_16x16x32_bf16 v[112:115], v[64:67], v[100:103], v[112:115]
    s_waitcnt lgkmcnt(3)
    v_mfma_f32_16x16x32_bf16 v[112:115], v[68:71], v[104:107], v[112:115]
    s_waitcnt lgkmcnt(0)
    v_mfma_f32_16x16x32_bf16 v[112:115], v[72:75], v[108:111], v[112:115]
    s_cmp_lg_u32 s30, 7
    s_cbranch_scc1 L_noml_14
    v_mov_b32 v120, 0x3f803f80
    v_mov_b32 v121, 0x3f803f80
    v_mov_b32 v122, 0x3f803f80
    v_mov_b32 v123, 0x3f803f80
    s_nop 1
    v_mfma_f32_16x16x32_bf16 v[116:119], v[120:123], v[96:99], 0
    v_mfma_f32_16x16x32_bf16 v[116:119], v[120:123], v[100:103], v[116:119]
    v_mfma_f32_16x16x32_bf16 v[116:119], v[120:123], v[104:107], v[116:119]
    v_mfma_f32_16x16x32_bf16 v[116:119], v[120:123], v[108:111], v[116:119]
L_noml_14:
    s_cmp_eq_u32 s67, 1
    s_nop 4
    v_bfi_b32 v112, s65, v156, v112
    v_bfi_b32 v113, s65, v157, v113
    v_bfi_b32 v114, s65, v158, v114
    v_bfi_b32 v115, s65, v159, v115
    s_mov_b32 exec_lo, 0x000f000f
    s_mov_b32 exec_hi, 0x000f000f
    s_cbranch_scc1 L_stl_15
    buffer_store_dwordx4 v[112:115], v137, s[60:63], s83 offen sc1
    s_branch L_std_16
L_stl_15:
    buffer_store_dwordx4 v[112:115], v137, s[60:63], s83 offen
L_std_16:
    s_mov_b64 exec, -1
    s_cmp_lg_u32 s30, 7
    s_cbranch_scc1 L_noml2_17
    v_bfi_b32 v124, s65, v156, v24
    v_bfi_b32 v125, s65, v157, v116
    v_mov_b32 v126, s64
    v_mov_b32 v127, s64
    s_mov_b64 exec, 0xf
    s_cmp_eq_u32 s67, 1

    s_cbranch_scc1 L_stl_18
    buffer_store_dwordx4 v[124:127], v143, s[60:63], s84 offen sc1
    s_branch L_std_19
L_stl_18:
    buffer_store_dwordx4 v[124:127], v143, s[60:63], s84 offen
L_std_19:
    s_mov_b64 exec, -1
L_noml2_17:
    s_barrier
    s_mov_b64 s[32:33], -1
    s_mov_b64 s[34:35], -1
    s_mov_b64 s[36:37], -1
    buffer_load_dwordx4 v[36:39], v141, s[60:63], s77 offen sc1
    buffer_load_dwordx4 v[44:47], v142, s[60:63], s78 offen offset:0 sc1
    buffer_load_dwordx4 v[48:51], v142, s[60:63], s78 offen offset:256 sc1
L_b1_20:
    s_waitcnt vmcnt(0)
    s_mov_b64 exec, s[34:35]
    v_cmpx_eq_u32_sdwa vcc, v44, s64 src0_sel:BYTE_0 src1_sel:BYTE_0
    v_cmpx_eq_u32_sdwa vcc, v45, s64 src0_sel:BYTE_0 src1_sel:BYTE_1
    v_cmpx_eq_u32_sdwa vcc, v46, s64 src0_sel:BYTE_0 src1_sel:BYTE_2
    v_cmpx_eq_u32_sdwa vcc, v47, s64 src0_sel:BYTE_0 src1_sel:BYTE_3
    s_andn2_b64 s[34:35], s[34:35], exec
    s_cbranch_scc0 L_aps_24
    s_mov_b64 exec, s[34:35]
    buffer_load_dwordx4 v[44:47], v142, s[60:63], s78 offen offset:0 sc1
L_aps_24:
    s_mov_b64 exec, s[36:37]
    v_cmpx_eq_u32_sdwa vcc, v48, s64 src0_sel:BYTE_0 src1_sel:BYTE_0
    v_cmpx_eq_u32_sdwa vcc, v49, s64 src0_sel:BYTE_0 src1_sel:BYTE_1
    v_cmpx_eq_u32_sdwa vcc, v50, s64 src0_sel:BYTE_0 src1_sel:BYTE_2
    v_cmpx_eq_u32_sdwa vcc, v51, s64 src0_sel:BYTE_0 src1_sel:BYTE_3
    s_andn2_b64 s[36:37], s[36:37], exec
    s_cbranch_scc0 L_aps_25
    s_mov_b64 exec, s[36:37]
    buffer_load_dwordx4 v[48:51], v142, s[60:63], s78 offen offset:256 sc1
L_aps_25:
    s_mov_b64 exec, s[32:33]
    v_cmpx_eq_u32_sdwa vcc, v36, s64 src0_sel:BYTE_0 src1_sel:BYTE_0
    v_cmpx_eq_u32_sdwa vcc, v37, s64 src0_sel:BYTE_0 src1_sel:BYTE_1
    v_cmpx_eq_u32 vcc, s64, v38
    s_andn2_b64 s[32:33], s[32:33], exec
    s_cbranch_scc0 L_b1o_21
    s_mov_b64 exec, s[32:33]
    buffer_load_dwordx4 v[36:39], v141, s[60:63], s77 offen sc1
    s_sub_u32 s97, s97, 1
    s_cbranch_scc1 L_end
    s_branch L_b1_20
L_b1o_21:
    s_mov_b64 exec, -1
    v_and_b32 v36, s66, v36
    v_and_b32 v37, s66, v37
    v_mov_b32 v22, v36
    s_nop 0
    s_nop 1
    v_max_f32_dpp v22, v22, v22 quad_perm:[1,0,3,2] row_mask:0xf bank_mask:0xf
    s_nop 1
    v_max_f32_dpp v22, v22, v22 quad_perm:[2,3,0,1] row_mask:0xf bank_mask:0xf
    s_nop 1
    v_max_f32_dpp v22, v22, v22 row_half_mirror row_mask:0xf bank_mask:0xf
    s_nop 1
    v_max_f32_dpp v22, v22, v22 row_mirror row_mask:0xf bank_mask:0xf
    v_mov_b32 v23, v22
    s_nop 1
    v_permlane16_swap_b32 v22, v23
    v_max_f32 v22, v22, v23
    v_sub_f32 v36, v36, v22
    v_mul_f32 v36, s94, v36
    v_exp_f32 v36, v36
    s_nop 0
    v_mul_f32 v22, v36, v37

    s_nop 1
    v_add_f32_dpp v22, v22, v22 quad_perm:[1,0,3,2] row_mask:0xf bank_mask:0xf
    s_nop 1
    v_add_f32_dpp v22, v22, v22 quad_perm:[2,3,0,1] row_mask:0xf bank_mask:0xf
    s_nop 1
    v_add_f32_dpp v22, v22, v22 row_half_mirror row_mask:0xf bank_mask:0xf
    s_nop 1
    v_add_f32_dpp v22, v22, v22 row_mirror row_mask:0xf bank_mask:0xf
    v_mov_b32 v23, v22
    s_nop 1
    v_permlane16_swap_b32 v22, v23
    v_add_f32 v22, v22, v23
    v_rcp_f32 v22, v22
    s_nop 0
    v_mul_f32 v36, v36, v22
    v_mov_b32 v38, v36
    s_nop 1
    v_permlane16_swap_b32 v36, v38
L_b2_22:
    s_or_b64 s[90:91], s[34:35], s[36:37]
    s_cbranch_scc0 L_b2o_23
    s_waitcnt vmcnt(0)

    s_mov_b64 exec, s[34:35]
    v_cmpx_eq_u32_sdwa vcc, v44, s64 src0_sel:BYTE_0 src1_sel:BYTE_0
    v_cmpx_eq_u32_sdwa vcc, v45, s64 src0_sel:BYTE_0 src1_sel:BYTE_1
    v_cmpx_eq_u32_sdwa vcc, v46, s64 src0_sel:BYTE_0 src1_sel:BYTE_2
    v_cmpx_eq_u32_sdwa vcc, v47, s64 src0_sel:BYTE_0 src1_sel:BYTE_3
    s_andn2_b64 s[34:35], s[34:35], exec
    s_cbranch_scc0 L_aps_26
    s_mov_b64 exec, s[34:35]
    buffer_load_dwordx4 v[44:47], v142, s[60:63], s78 offen offset:0 sc1
L_aps_26:
    s_mov_b64 exec, s[36:37]
    v_cmpx_eq_u32_sdwa vcc, v48, s64 src0_sel:BYTE_0 src1_sel:BYTE_0
    v_cmpx_eq_u32_sdwa vcc, v49, s64 src0_sel:BYTE_0 src1_sel:BYTE_1
    v_cmpx_eq_u32_sdwa vcc, v50, s64 src0_sel:BYTE_0 src1_sel:BYTE_2
    v_cmpx_eq_u32_sdwa vcc, v51, s64 src0_sel:BYTE_0 src1_sel:BYTE_3
    s_andn2_b64 s[36:37], s[36:37], exec
    s_cbranch_scc0 L_aps_27
    s_mov_b64 exec, s[36:37]
    buffer_load_dwordx4 v[48:51], v142, s[60:63], s78 offen offset:256 sc1
L_aps_27:
    s_mov_b64 exec, -1
    s_sub_u32 s97, s97, 1
    s_cbranch_scc1 L_end
    s_branch L_b2_22
L_b2o_23:
    v_and_b32 v44, s66, v44
    v_and_b32 v45, s66, v45
    v_and_b32 v46, s66, v46
    v_and_b32 v47, s66, v47
    v_and_b32 v48, s66, v48
    v_and_b32 v49, s66, v49
    v_and_b32 v50, s66, v50
    v_and_b32 v51, s66, v51
    v_mul_f32 v44, v36, v44
    v_mul_f32 v45, v36, v45
    v_mul_f32 v46, v36, v46
    v_mul_f32 v47, v36, v47
    v_fmac_f32 v44, v38, v48
    v_fmac_f32 v45, v38, v49
    v_fmac_f32 v46, v38, v50
    v_fmac_f32 v47, v38, v51
    v_add_f32_dpp v22, v44, v44 row_ror:8 row_mask:0xf bank_mask:0x3
    v_add_f32_dpp v22, v45, v45 row_ror:8 row_mask:0xf bank_mask:0xc
    v_add_f32_dpp v23, v46, v46 row_ror:8 row_mask:0xf bank_mask:0x3
    v_add_f32_dpp v23, v47, v47 row_ror:8 row_mask:0xf bank_mask:0xc

    s_nop 0
    v_add_f32_dpp v22, v22, v22 quad_perm:[1,0,3,2] row_mask:0xf bank_mask:0xf
    v_add_f32_dpp v23, v23, v23 quad_perm:[1,0,3,2] row_mask:0xf bank_mask:0xf
    s_nop 0
    v_add_f32_dpp v22, v22, v22 quad_perm:[2,3,0,1] row_mask:0xf bank_mask:0xf
    v_add_f32_dpp v23, v23, v23 quad_perm:[2,3,0,1] row_mask:0xf bank_mask:0xf
    s_nop 0
    v_add_f32_dpp v22, v22, v22 row_half_mirror row_mask:0xf bank_mask:0xf
    v_add_f32_dpp v23, v23, v23 row_half_mirror row_mask:0xf bank_mask:0xf
    v_cvt_pk_bf16_f32 v22, v22, v22
    v_cvt_pk_bf16_f32 v23, v23, v23
    v_and_b32 v120, v22, v6
    v_and_b32 v121, v22, v7
    v_and_b32 v122, v22, v8
    v_and_b32 v123, v22, v9
    v_and_b32 v124, v23, v6
    v_and_b32 v125, v23, v7
    v_and_b32 v126, v23, v8
    v_and_b32 v127, v23, v9
    v_mfma_f32_16x16x32_bf16 v[112:115], v[76:79], v[120:123], 0
    s_nop 0
    v_mfma_f32_16x16x32_bf16 v[112:115], v[80:83], v[124:127], v[112:115]
    s_nop 5
    s_mov_b32 exec_lo, 0x00ff00ff
    s_mov_b32 exec_hi, 0xff00ff00
    ds_write_b128 v17, v[112:115] offset:24832
    s_mov_b64 exec, -1
    s_waitcnt lgkmcnt(0)
    s_barrier
    s_cmp_lg_u32 s30, 0
    s_cbranch_scc1 L_wpskip_28
    ds_read_b128 v[96:99], v12 offset:24832
    ds_read_b128 v[100:103], v12 offset:25088
    ds_read_b128 v[104:107], v12 offset:25360
    ds_read_b128 v[108:111], v12 offset:25616
    s_waitcnt lgkmcnt(2)
    v_pk_add_f32 v[96:97], v[96:97], v[100:101]
    v_pk_add_f32 v[98:99], v[98:99], v[102:103]
    s_waitcnt lgkmcnt(0)
    v_pk_add_f32 v[104:105], v[104:105], v[108:109]
    v_pk_add_f32 v[106:107], v[106:107], v[110:111]
    v_pk_add_f32 v[96:97], v[96:97], v[104:105]
    v_pk_add_f32 v[98:99], v[98:99], v[106:107]
    s_nop 0

    v_add_f32_dpp v96, v96, v96 quad_perm:[1,0,3,2] row_mask:0xf bank_mask:0xf
    v_add_f32_dpp v97, v97, v97 quad_perm:[1,0,3,2] row_mask:0xf bank_mask:0xf
    v_add_f32_dpp v98, v98, v98 quad_perm:[1,0,3,2] row_mask:0xf bank_mask:0xf
    v_add_f32_dpp v99, v99, v99 quad_perm:[1,0,3,2] row_mask:0xf bank_mask:0xf
    v_add_f32_dpp v96, v96, v96 quad_perm:[2,3,0,1] row_mask:0xf bank_mask:0xf
    v_add_f32_dpp v97, v97, v97 quad_perm:[2,3,0,1] row_mask:0xf bank_mask:0xf
    v_add_f32_dpp v98, v98, v98 quad_perm:[2,3,0,1] row_mask:0xf bank_mask:0xf
    v_add_f32_dpp v99, v99, v99 quad_perm:[2,3,0,1] row_mask:0xf bank_mask:0xf
    v_bfi_b32 v96, s65, v156, v96
    v_bfi_b32 v97, s65, v157, v97
    v_bfi_b32 v98, s65, v158, v98
    v_bfi_b32 v99, s65, v159, v99
    s_mov_b32 exec_lo, 0x11111111
    s_mov_b32 exec_hi, 0x11111111
    buffer_store_dwordx4 v[96:99], v13, s[60:63], s79 offen sc1
    s_mov_b64 exec, -1
    s_nop 1

L_wpskip_28:
    s_barrier
    s_cmp_ge_u32 s81, 28
    s_cbranch_scc1 L_noffnld_29
    buffer_load_dwordx4 v[92:95], v134, s[56:59], s82 offen nt
L_noffnld_29:
    s_cmp_ge_u32 s81, 28
    s_cbranch_scc1 L_fin
    s_waitcnt vmcnt(0)
    s_mov_b32 s32, -1
    s_mov_b32 s33, -1
    buffer_load_dwordx4 v[52:55], v18, s[60:63], s85 offen sc1
L_mc_30:
    s_mov_b64 exec, s[32:33]
    s_waitcnt vmcnt(0)
    v_cmpx_eq_u32_sdwa vcc, v52, s64 src0_sel:BYTE_0 src1_sel:BYTE_0
    v_cmpx_eq_u32_sdwa vcc, v53, s64 src0_sel:BYTE_0 src1_sel:BYTE_1
    v_cmpx_eq_u32_sdwa vcc, v54, s64 src0_sel:BYTE_0 src1_sel:BYTE_2
    v_cmpx_eq_u32_sdwa vcc, v55, s64 src0_sel:BYTE_0 src1_sel:BYTE_3
    s_andn2_b64 s[32:33], s[32:33], exec
    s_cbranch_scc0 L_mo_31
    s_mov_b64 exec, s[32:33]
    buffer_load_dwordx4 v[52:55], v18, s[60:63], s85 offen sc1
    s_sub_u32 s97, s97, 1
    s_cbranch_scc1 L_end
    s_branch L_mc_30
L_mo_31:
    s_mov_b64 exec, -1
    v_and_b32 v52, s66, v52
    v_and_b32 v53, s66, v53
    v_and_b32 v54, s66, v54
    v_and_b32 v55, s66, v55
    s_nop 0
    v_permlane32_swap_b32 v52, v54
    v_permlane32_swap_b32 v53, v55
    v_add_f32 v52, v52, v54
    v_add_f32 v53, v53, v55
    s_nop 1
    v_permlane16_swap_b32 v52, v53
    v_add_f32 v16, v52, v53

    s_nop 1
    v_add_f32_dpp v16, v16, v16 row_ror:8 row_mask:0xf bank_mask:0xf
    s_nop 1
    v_add_f32_dpp v16, v16, v16 row_ror:4 row_mask:0xf bank_mask:0xf
    s_nop 1
    v_add_f32_dpp v16, v16, v16 row_ror:2 row_mask:0xf bank_mask:0xf
    v_cvt_pk_bf16_f32 v16, v16, v16
    v_and_b32 v16, 0xffff0000, v16
    v_add_f32 v16, v16, v15
    v_cvt_pk_bf16_f32 v22, v16, v16
    v_and_b32 v16, 0xffff0000, v22
    s_nop 0
    v_mov_b32_dpp v160, v22 quad_perm:[0,0,0,0] row_mask:0xf bank_mask:0x3
    v_mov_b32_dpp v161, v22 quad_perm:[1,1,1,1] row_mask:0xf bank_mask:0x3

    v_and_b32 v120, v160, v6
    v_and_b32 v121, v160, v7
    v_and_b32 v122, v160, v8
    v_and_b32 v123, v160, v9
    v_and_b32 v124, v161, v6
    v_and_b32 v125, v161, v7
    v_and_b32 v126, v161, v8
    v_and_b32 v127, v161, v9
    v_mfma_f32_16x16x32_bf16 v[112:115], v[84:87], v[120:123], 0
    v_mul_f32 v23, v16, v16
    v_mfma_f32_16x16x32_bf16 v[112:115], v[88:91], v[124:127], v[112:115]
    v_add_f32_dpp v22, v16, v16 quad_perm:[1,0,3,2] row_mask:0xf bank_mask:0xf
    v_add_f32_dpp v23, v23, v23 quad_perm:[1,0,3,2] row_mask:0xf bank_mask:0xf
    v_mov_b32 v30, v22
    v_mov_b32 v31, v23
    s_nop 0
    v_permlane16_swap_b32 v22, v30
    v_permlane16_swap_b32 v23, v31
    v_add_f32 v22, v22, v30
    v_add_f32 v23, v23, v31

    ds_write_b128 v144, v[112:115] offset:0
    v_mov_b32 v30, v22
    v_mov_b32 v31, v23
    s_nop 0
    v_permlane32_swap_b32 v22, v30
    v_permlane32_swap_b32 v23, v31
    v_add_f32 v22, v22, v30
    v_add_f32 v23, v23, v31

    s_mov_b64 exec, 1
    ds_write_b64 v148, v[22:23] offset:22528
    s_mov_b64 exec, -1
    s_waitcnt lgkmcnt(0)
    s_barrier

    ds_read_b32 v96, v145 offset:0
    ds_read_b32 v97, v145 offset:512
    ds_read_b32 v98, v145 offset:128
    ds_read_b32 v99, v145 offset:640
    ds_read_b64 v[100:101], v146 offset:22528
    s_cmp_eq_u32 s67, 1
    s_waitcnt lgkmcnt(1)
    v_add_f32_dpp v96, v96, v96 quad_perm:[1,0,3,2] row_mask:0xf bank_mask:0xf
    v_add_f32_dpp v97, v97, v97 quad_perm:[1,0,3,2] row_mask:0xf bank_mask:0xf
    v_add_f32_dpp v98, v98, v98 quad_perm:[1,0,3,2] row_mask:0xf bank_mask:0xf
    v_add_f32_dpp v99, v99, v99 quad_perm:[1,0,3,2] row_mask:0xf bank_mask:0xf
    v_add_f32_dpp v96, v96, v96 quad_perm:[2,3,0,1] row_mask:0xf bank_mask:0xf
    v_add_f32_dpp v97, v97, v97 quad_perm:[2,3,0,1] row_mask:0xf bank_mask:0xf
    v_add_f32_dpp v98, v98, v98 quad_perm:[2,3,0,1] row_mask:0xf bank_mask:0xf
    v_add_f32_dpp v99, v99, v99 quad_perm:[2,3,0,1] row_mask:0xf bank_mask:0xf
    v_add_f32_dpp v96, v96, v96 row_half_mirror row_mask:0xf bank_mask:0xf
    v_add_f32_dpp v97, v97, v97 row_half_mirror row_mask:0xf bank_mask:0xf
    v_add_f32_dpp v98, v98, v98 row_half_mirror row_mask:0xf bank_mask:0xf
    v_add_f32_dpp v99, v99, v99 row_half_mirror row_mask:0xf bank_mask:0xf
    v_bfi_b32 v96, s65, v156, v96
    v_bfi_b32 v97, s65, v157, v97
    v_bfi_b32 v98, s65, v158, v98
    v_bfi_b32 v99, s65, v159, v99
    s_mov_b32 exec_lo, 0x01010101
    s_mov_b32 exec_hi, 0x01010101
    s_cbranch_scc1 L_stl_32
    buffer_store_dwordx4 v[96:99], v147, s[60:63], s96 offen sc1
    s_branch L_std_33
L_stl_32:
    buffer_store_dwordx4 v[96:99], v147, s[60:63], s96 offen
L_std_33:
    s_mov_b64 exec, -1
    s_cmp_lg_u32 s30, 7
    s_cbranch_scc1 L_nost_34
    s_waitcnt lgkmcnt(0)
    s_nop 0
    v_add_f32_dpp v100, v100, v100 quad_perm:[1,0,3,2] row_mask:0xf bank_mask:0xf
    v_add_f32_dpp v101, v101, v101 quad_perm:[1,0,3,2] row_mask:0xf bank_mask:0xf
    s_nop 0
    v_add_f32_dpp v100, v100, v100 quad_perm:[2,3,0,1] row_mask:0xf bank_mask:0xf
    v_add_f32_dpp v101, v101, v101 quad_perm:[2,3,0,1] row_mask:0xf bank_mask:0xf
    s_nop 0
    v_add_f32_dpp v100, v100, v100 row_half_mirror row_mask:0xf bank_mask:0xf
    v_add_f32_dpp v101, v101, v101 row_half_mirror row_mask:0xf bank_mask:0xf
    v_bfi_b32 v100, s65, v156, v100
    v_bfi_b32 v101, s65, v157, v101
    v_mov_b32 v102, s64
    v_mov_b32 v103, s64
    s_mov_b64 exec, 1
    s_cmp_eq_u32 s67, 1

    s_cbranch_scc1 L_stl_35
    buffer_store_dwordx4 v[100:103], v163, s[60:63], s4 offen sc1
    s_branch L_std_36
L_stl_35:
    buffer_store_dwordx4 v[100:103], v163, s[60:63], s4 offen
L_std_36:
    s_mov_b64 exec, -1
    s_nop 1
L_nost_34:
    s_waitcnt lgkmcnt(0)
    s_barrier
    s_mov_b32 s32, -1
    s_mov_b32 s33, -1
    buffer_load_dwordx4 v[60:63], v149, s[60:63], s5 offen sc1
    s_mov_b32 s34, -1
    s_mov_b32 s35, -1
    buffer_load_dwordx4 v[64:67], v150, s[60:63], s6 offen sc1
L_mc_37:
    s_mov_b64 exec, s[32:33]
    s_waitcnt vmcnt(0)
    v_cmpx_eq_u32_sdwa vcc, v60, s64 src0_sel:BYTE_0 src1_sel:BYTE_0
    v_cmpx_eq_u32_sdwa vcc, v61, s64 src0_sel:BYTE_0 src1_sel:BYTE_1
    v_cmpx_eq_u32_sdwa vcc, v62, s64 src0_sel:BYTE_0 src1_sel:BYTE_2
    v_cmpx_eq_u32_sdwa vcc, v63, s64 src0_sel:BYTE_0 src1_sel:BYTE_3
    s_andn2_b64 s[40:41], s[32:33], exec
    s_mov_b64 exec, s[34:35]
    v_cmpx_eq_u32_sdwa vcc, v64, s64 src0_sel:BYTE_0 src1_sel:BYTE_0
    v_cmpx_eq_u32_sdwa vcc, v65, s64 src0_sel:BYTE_0 src1_sel:BYTE_1
    v_cmpx_eq_u32 vcc, s64, v66
    s_andn2_b64 s[42:43], s[34:35], exec
    s_or_b64 s[90:91], s[40:41], s[42:43]
    s_cbranch_scc0 L_mo_38
    s_mov_b64 s[32:33], s[40:41]
    s_mov_b64 exec, s[32:33]
    s_cbranch_execz L_ms_39
    buffer_load_dwordx4 v[60:63], v149, s[60:63], s5 offen sc1
L_ms_39:
    s_mov_b64 s[34:35], s[42:43]
    s_mov_b64 exec, s[34:35]
    s_cbranch_execz L_ms_40
    buffer_load_dwordx4 v[64:67], v150, s[60:63], s6 offen sc1
L_ms_40:
    s_sub_u32 s97, s97, 1
    s_cbranch_scc1 L_end
    s_branch L_mc_37
L_mo_38:
    s_mov_b64 exec, -1
    v_and_b32 v64, s66, v64
    v_and_b32 v65, s66, v65
    v_and_b32 v60, s66, v60
    v_and_b32 v61, s66, v61
    v_and_b32 v62, s66, v62
    v_and_b32 v63, s66, v63
    v_add_f32_dpp v64, v64, v64 quad_perm:[1,0,3,2] row_mask:0xf bank_mask:0xf
    v_add_f32_dpp v65, v65, v65 quad_perm:[1,0,3,2] row_mask:0xf bank_mask:0xf
    v_add_f32_dpp v60, v60, v60 quad_perm:[1,0,3,2] row_mask:0xf bank_mask:0xf
    v_add_f32_dpp v61, v61, v61 quad_perm:[1,0,3,2] row_mask:0xf bank_mask:0xf
    v_add_f32_dpp v62, v62, v62 quad_perm:[1,0,3,2] row_mask:0xf bank_mask:0xf
    v_add_f32_dpp v63, v63, v63 quad_perm:[1,0,3,2] row_mask:0xf bank_mask:0xf
    v_add_f32_dpp v64, v64, v64 quad_perm:[2,3,0,1] row_mask:0xf bank_mask:0xf
    v_add_f32_dpp v65, v65, v65 quad_perm:[2,3,0,1] row_mask:0xf bank_mask:0xf
    v_add_f32_dpp v60, v60, v60 quad_perm:[2,3,0,1] row_mask:0xf bank_mask:0xf
    v_add_f32_dpp v61, v61, v61 quad_perm:[2,3,0,1] row_mask:0xf bank_mask:0xf
    v_add_f32_dpp v62, v62, v62 quad_perm:[2,3,0,1] row_mask:0xf bank_mask:0xf
    v_add_f32_dpp v63, v63, v63 quad_perm:[2,3,0,1] row_mask:0xf bank_mask:0xf
    v_add_f32_dpp v64, v64, v64 row_half_mirror row_mask:0xf bank_mask:0xf
    v_add_f32_dpp v65, v65, v65 row_half_mirror row_mask:0xf bank_mask:0xf
    v_add_f32_dpp v60, v60, v60 row_half_mirror row_mask:0xf bank_mask:0xf
    v_add_f32_dpp v61, v61, v61 row_half_mirror row_mask:0xf bank_mask:0xf
    v_add_f32_dpp v62, v62, v62 row_half_mirror row_mask:0xf bank_mask:0xf
    v_add_f32_dpp v63, v63, v63 row_half_mirror row_mask:0xf bank_mask:0xf
    v_mul_f32 v64, 0x3b000000, v64
    v_mul_f32 v65, 0x3b000000, v65
    v_fma_f32 v65, -v64, v64, v65
    v_max_f32 v65, 0, v65
    v_cvt_pk_bf16_f32 v65, v65, v64
    v_and_b32 v64, 0xffff0000, v65
    v_lshlrev_b32 v65, 16, v65
    v_add_f32 v65, 0x3727c5ac, v65

    v_cvt_pk_bf16_f32 v65, v65, v65
    v_and_b32 v65, 0xffff0000, v65
    v_sqrt_f32 v65, v65
    s_nop 0
    v_cvt_pk_bf16_f32 v65, v65, v65
    v_and_b32 v65, 0xffff0000, v65
    v_rcp_f32 v65, v65
    v_fma_f32 v60, -v64, v62, v60
    v_fma_f32 v61, -v64, v63, v61
    v_mul_f32 v60, v60, v65
    v_mul_f32 v61, v61, v65
    v_cvt_pk_bf16_f32 v22, v60, v61
    v_lshlrev_b32 v60, 16, v22
    v_mul_f32 v62, 0xbfb8aa3b, v60
    v_exp_f32 v62, v62
    v_and_b32 v61, 0xffff0000, v22
    v_add_f32 v62, 1.0, v62
    v_rcp_f32 v62, v62
    s_nop 0
    v_mul_f32 v22, v60, v62

    v_cvt_pk_bf16_f32 v22, v22, v22
    v_and_b32 v22, 0xffff0000, v22
    v_mul_f32 v22, v22, v61
    v_cvt_pk_bf16_f32 v22, v22, v22
    v_and_b32 v120, v22, v6
    v_and_b32 v121, v22, v7
    v_and_b32 v122, v22, v8
    v_and_b32 v123, v22, v9
    s_nop 1
    v_mfma_f32_16x16x32_bf16 v[112:115], v[92:95], v[120:123], 0
    v_mov_b32 v52, 0
    v_mov_b32 v53, 0
    v_mov_b32 v54, 0
    v_mov_b32 v55, 0
    s_nop 1

    s_mov_b32 exec_lo, 0x00ff00ff
    s_mov_b32 exec_hi, 0xff00ff00
    ds_write_b128 v17, v[112:115] offset:24832
    s_mov_b64 exec, -1
    s_waitcnt lgkmcnt(0)
    s_barrier
    s_cmp_lg_u32 s30, 0
    s_cbranch_scc1 L_opskip_41
    ds_read_b128 v[96:99], v12 offset:24832
    ds_read_b128 v[100:103], v12 offset:25088
    ds_read_b128 v[104:107], v12 offset:25360
    ds_read_b128 v[108:111], v12 offset:25616
    s_waitcnt lgkmcnt(2)
    v_pk_add_f32 v[96:97], v[96:97], v[100:101]
    v_pk_add_f32 v[98:99], v[98:99], v[102:103]
    s_waitcnt lgkmcnt(0)
    v_pk_add_f32 v[104:105], v[104:105], v[108:109]
    v_pk_add_f32 v[106:107], v[106:107], v[110:111]
    v_pk_add_f32 v[96:97], v[96:97], v[104:105]
    v_pk_add_f32 v[98:99], v[98:99], v[106:107]
    s_nop 0

    v_add_f32_dpp v96, v96, v96 quad_perm:[1,0,3,2] row_mask:0xf bank_mask:0xf
    v_add_f32_dpp v97, v97, v97 quad_perm:[1,0,3,2] row_mask:0xf bank_mask:0xf
    v_add_f32_dpp v98, v98, v98 quad_perm:[1,0,3,2] row_mask:0xf bank_mask:0xf
    v_add_f32_dpp v99, v99, v99 quad_perm:[1,0,3,2] row_mask:0xf bank_mask:0xf
    v_add_f32_dpp v96, v96, v96 quad_perm:[2,3,0,1] row_mask:0xf bank_mask:0xf
    v_add_f32_dpp v97, v97, v97 quad_perm:[2,3,0,1] row_mask:0xf bank_mask:0xf
    v_add_f32_dpp v98, v98, v98 quad_perm:[2,3,0,1] row_mask:0xf bank_mask:0xf
    v_add_f32_dpp v99, v99, v99 quad_perm:[2,3,0,1] row_mask:0xf bank_mask:0xf
    v_bfi_b32 v96, s65, v156, v96
    v_bfi_b32 v97, s65, v157, v97
    v_bfi_b32 v98, s65, v158, v98
    v_bfi_b32 v99, s65, v159, v99
    s_mov_b32 exec_lo, 0x11111111
    s_mov_b32 exec_hi, 0x11111111
    buffer_store_dwordx4 v[96:99], v13, s[60:63], s7 offen sc1
    s_mov_b64 exec, -1
    s_nop 1

    s_waitcnt vmcnt(0)
L_opskip_41:
    s_barrier
    s_cmp_lg_u32 s29, s28
    s_cbranch_scc1 L_fin
    s_mov_b32 s32, -1
    s_mov_b32 s33, 0x00ffffff
    s_mov_b64 exec, s[32:33]
    buffer_load_dwordx4 v[52:55], v18, s[60:63], s8 offen sc1
L_mc_42:
    s_mov_b64 exec, s[32:33]
    s_waitcnt vmcnt(0)
    v_cmpx_eq_u32_sdwa vcc, v52, s64 src0_sel:BYTE_0 src1_sel:BYTE_0
    v_cmpx_eq_u32_sdwa vcc, v53, s64 src0_sel:BYTE_0 src1_sel:BYTE_1
    v_cmpx_eq_u32_sdwa vcc, v54, s64 src0_sel:BYTE_0 src1_sel:BYTE_2
    v_cmpx_eq_u32_sdwa vcc, v55, s64 src0_sel:BYTE_0 src1_sel:BYTE_3
    s_andn2_b64 s[32:33], s[32:33], exec
    s_cbranch_scc0 L_mo_43
    s_mov_b64 exec, s[32:33]
    buffer_load_dwordx4 v[52:55], v18, s[60:63], s8 offen sc1
    s_sub_u32 s97, s97, 1
    s_cbranch_scc1 L_end
    s_branch L_mc_42
L_mo_43:
    s_mov_b64 exec, -1
    v_and_b32 v52, s66, v52
    v_and_b32 v53, s66, v53
    v_and_b32 v54, s66, v54
    v_and_b32 v55, s66, v55
    s_nop 0
    v_permlane32_swap_b32 v52, v54
    v_permlane32_swap_b32 v53, v55
    v_add_f32 v52, v52, v54
    v_add_f32 v53, v53, v55
    s_nop 1
    v_permlane16_swap_b32 v52, v53
    v_add_f32 v22, v52, v53

    s_nop 1
    v_add_f32_dpp v22, v22, v22 row_ror:8 row_mask:0xf bank_mask:0xf
    s_nop 1
    v_add_f32_dpp v22, v22, v22 row_ror:4 row_mask:0xf bank_mask:0xf
    s_nop 1
    v_add_f32_dpp v22, v22, v22 row_ror:2 row_mask:0xf bank_mask:0xf
    v_cvt_pk_bf16_f32 v22, v22, v22
    v_and_b32 v22, 0xffff0000, v22
    v_add_f32 v22, v22, v16
    v_cvt_pk_bf16_f32 v22, v22, v22
    s_mov_b32 exec_lo, 0x00030003
    s_mov_b32 exec_hi, 0x00030003
    buffer_store_short v22, v151, s[52:55], s9 offen
    s_mov_b64 exec, -1
    s_cmp_lg_u32 s2, 0
    s_cbranch_scc1 L_fin
    s_cmp_lg_u32 s30, 0
    s_cbranch_scc1 L_fin
    s_mov_b64 exec, 1
    buffer_store_dword v156, v163, s[60:63], 0 offen sc1
    s_mov_b64 exec, -1
L_fin:

L_end:
    s_endpgm
.section .rodata,"a"
.p2align 6
.amdhsa_kernel sequential_preLN__sliding_block_cached__glu_gated_swiglu__decode_kernel
  .amdhsa_next_free_vgpr 168
  .amdhsa_next_free_sgpr 102
  .amdhsa_accum_offset 168
  .amdhsa_group_segment_fixed_size 0
  .amdhsa_kernarg_size 96
  .amdhsa_user_sgpr_count 2
  .amdhsa_user_sgpr_kernarg_segment_ptr 1
  .amdhsa_system_sgpr_workgroup_id_x 1
.end_amdhsa_kernel
```
